```python
import torch

def _softmax(x, axis=-1):
    return torch.softmax(x, dim=axis)
def _gelu(x):
    return torch.nn.functional.gelu(x, approximate="tanh")
def _silu(x):
    return torch.nn.functional.silu(x)
def _sigmoid(x):
    return torch.sigmoid(x)
def _layernorm(x, axis=-1, eps=1e-5):
    m = x.mean(dim=axis, keepdim=True)
    v = x.var(dim=axis, keepdim=True, unbiased=False)
    return (x - m) / torch.sqrt(v + eps)
def _scatter_add(tgt, idx, src, axis=0):
    return tgt.clone().index_add_(axis, idx, src)
def _segment_sum(src, seg, n):
    out = torch.zeros((n,) + src.shape[1:], dtype=src.dtype)
    return out.index_add_(0, seg, src)
def _pad(x, pw):
    flat = tuple(v for pair in reversed(pw) for v in pair)
    return torch.nn.functional.pad(x, flat)

kernel_name = 'standalone__sliding_block_cached__sampling'

def setup_inputs():

    _w = (lambda a: (lambda t: t.to(torch.bfloat16) if t.is_floating_point() else t)(torch.as_tensor(a)))
    B, Sq, D = 16, 1, 576
    Hq, Hkv, Sk, Dh = 32, 16, 4096, 128
    assert Hq % Hkv == 0, (Hq, Hkv)
    return {
        "x": _w((lambda *s: torch.randn(*s, dtype=torch.bfloat16) * 0.8)(B, Sq, D)),
        "k_cache": _w((lambda *s: torch.randn(*s, dtype=torch.bfloat16) * 0.8)(B, Hkv, Sk, Dh)),
        "v_cache": _w((lambda *s: torch.randn(*s, dtype=torch.bfloat16) * 0.05)(B, Hkv, Sk, Dh)),
        "wq": _w((lambda *s: torch.randn(*s, dtype=torch.bfloat16) * 0.8)(D, Hq * Dh) * (D ** -0.5)),
        "wo": _w((lambda *s: torch.randn(*s, dtype=torch.bfloat16) * 0.05)(Hq * Dh, D) * ((Hq * Dh) ** -0.5)),
    }

def reference(x, k_cache, v_cache, wq, wo):
    B, Sq, D = x.shape
    Hq, Dh = 32, 128
    Hkv, Sk = k_cache.shape[1], k_cache.shape[2]
    W = min(4096, max(256, Sk // 4))
    rep = Hq // Hkv
    q = (lambda x, *d: x.permute(*d))((x @ wq).reshape(B, Sq, Hq, Dh), 0, 2, 1, 3)
    k = (lambda x, n, axis: torch.repeat_interleave(x, n, dim=axis))(k_cache[:, :, Sk - W:, :], rep, axis=1)
    v = (lambda x, n, axis: torch.repeat_interleave(x, n, dim=axis))(v_cache[:, :, Sk - W:, :], rep, axis=1)
    scores = torch.einsum("bhqd,bhkd->bhqk", q, k) * (Dh ** -0.5)
    p = _softmax(scores, axis=-1)
    o = torch.einsum("bhqk,bhkd->bhqd", p, v)
    return (lambda x, *d: x.permute(*d))(o, 0, 2, 1, 3).reshape(B, Sq, Hq * Dh) @ wo
```

```asm
; @launch grid=(256,1,1) block=(512,1,1) lds=60416
.amdgcn_target "amdgcn-amd-amdhsa--gfx950"
.text
.globl standalone__sliding_block_cached__sampling_kernel
.p2align 8
.type standalone__sliding_block_cached__sampling_kernel,@function
standalone__sliding_block_cached__sampling_kernel:
  s_cmp_ge_u32 s2, 256
  s_cbranch_scc1 L_done
  s_load_dwordx16 s[64:79], s[0:1], 0
  v_and_b32 v1, 63, v0
  v_lshrrev_b32 v6, 6, v0
  v_lshrrev_b32 v4, 4, v1
  v_readfirstlane_b32 s3, v6
  v_and_b32 v5, 15, v1
  s_and_b32 s4, s2, 7
  s_lshl_b32 s4, s4, 1
  s_bfe_u32 s40, s2, 0x10003
  s_or_b32 s4, s4, s40
  s_lshr_b32 s5, s2, 4
  s_mov_b32 s6, 0
  v_bfe_u32 v6, v5, 1, 1
  v_lshlrev_b32 v6, 10, v6
  v_lshrrev_b32 v7, 2, v5
  v_lshl_add_u32 v6, v7, 8, v6
  v_and_b32 v7, 1, v5
  v_lshl_add_u32 v6, v7, 6, v6
  v_lshl_add_u32 v2, v4, 4, v6
  v_lshlrev_b32 v3, 4, v1
  s_lshl_b32 s48, s3, 13
  s_add_u32 s49, s48, 4096
  s_add_u32 s50, s48, 65536
  s_add_u32 s51, s48, 69632
  s_add_u32 s52, s48, 131072
  s_add_u32 s53, s48, 135168
  s_add_u32 s54, s48, 196608
  s_add_u32 s55, s48, 200704
  s_mov_b32 s44, 0x05040100
  s_mov_b32 s45, 0x07060302
  s_lshl_b32 s40, s5, 4
  s_or_b32 s40, s40, s4
  s_lshl_b32 s40, s40, 20
  s_add_u32 s40, s40, 786432
  s_and_b32 s41, s4, 7
  s_lshr_b32 s42, s4, 3
  v_mul_u32_u24 v12, 1152, v5
  v_lshl_add_u32 v12, v4, 4, v12
  s_mul_i32 s43, s42, 576
  v_lshrrev_b32 v13, 2, v1
  v_lshlrev_b32 v13, 13, v13
  v_and_b32 v14, 3, v1
  v_lshl_add_u32 v13, v14, 4, v13
  s_mul_i32 s60, s42, 2359296
  s_lshl_b32 s46, s5, 9
  s_add_u32 s60, s60, s46
  s_lshl_b32 s46, s41, 6
  s_add_u32 s60, s60, s46
  s_lshl_b32 s63, s5, 15
  s_lshl_b32 s42, s42, 10
  s_add_u32 s63, s63, s42
  s_lshl_b32 s41, s41, 7
  s_add_u32 s63, s63, s41
  s_lshl_b32 s62, s4, 4
  s_add_u32 s62, s62, s5
  s_cmp_lg_u32 s3, 1
  s_cbranch_scc1 L_p0
  v_mov_b32 v15, 0
  ds_write_b32 v15, v15 offset:768
L_p0:
  s_waitcnt lgkmcnt(0)
  s_barrier
  s_add_u32 s8, s66, s40
  s_addc_u32 s9, s67, 0
  s_and_b32 s9, s9, 0xffff
  s_mov_b32 s10, 262144
  s_mov_b32 s11, 0x20000
  s_mov_b32 s16, s70
  s_and_b32 s17, s71, 0xffff
  s_mov_b32 s18, 4718592
  s_mov_b32 s19, 0x20000
  s_mov_b32 s20, s64
  s_and_b32 s21, s65, 0xffff
  s_mov_b32 s22, 18432
  s_mov_b32 s23, 0x20000
  s_mov_b32 s32, s78
  s_and_b32 s33, s79, 0xffff
  s_mov_b32 s34, 4194304
  s_mov_b32 s35, 0x20000
  s_cmp_lg_u32 s3, 0
  s_cbranch_scc1 L_p1
  s_mov_b32 m0, 41984
  s_add_u32 s46, s60, 0
  buffer_load_dwordx4 v13, s[16:19], s46 offen nt lds
  s_mov_b32 m0, 43008
  s_add_u32 s46, s60, 131072
  buffer_load_dwordx4 v13, s[16:19], s46 offen nt lds
  buffer_load_dwordx4 v[32:35], v12, s[20:23], s43 offen offset:0
  s_mov_b32 m0, 44032
  s_add_u32 s46, s60, 262144
  buffer_load_dwordx4 v13, s[16:19], s46 offen nt lds
  s_mov_b32 m0, 45056
  s_add_u32 s46, s60, 393216
  buffer_load_dwordx4 v13, s[16:19], s46 offen nt lds
  buffer_load_dwordx4 v[36:39], v12, s[20:23], s43 offen offset:64
  s_mov_b32 m0, 46080
  s_add_u32 s46, s60, 524288
  buffer_load_dwordx4 v13, s[16:19], s46 offen nt lds
  s_mov_b32 m0, 47104
  s_add_u32 s46, s60, 655360
  buffer_load_dwordx4 v13, s[16:19], s46 offen nt lds
  buffer_load_dwordx4 v[40:43], v12, s[20:23], s43 offen offset:128
  s_mov_b32 m0, 48128
  s_add_u32 s46, s60, 786432
  buffer_load_dwordx4 v13, s[16:19], s46 offen nt lds
  s_mov_b32 m0, 49152
  s_add_u32 s46, s60, 917504
  buffer_load_dwordx4 v13, s[16:19], s46 offen nt lds
  buffer_load_dwordx4 v[44:47], v12, s[20:23], s43 offen offset:192
  s_mov_b32 m0, 50176
  s_add_u32 s46, s60, 1048576
  buffer_load_dwordx4 v13, s[16:19], s46 offen nt lds
  s_mov_b32 m0, 51200
  s_add_u32 s46, s60, 1179648
  buffer_load_dwordx4 v13, s[16:19], s46 offen nt lds
  buffer_load_dwordx4 v[48:51], v12, s[20:23], s43 offen offset:256
  s_mov_b32 m0, 52224
  s_add_u32 s46, s60, 1310720
  buffer_load_dwordx4 v13, s[16:19], s46 offen nt lds
  s_mov_b32 m0, 53248
  s_add_u32 s46, s60, 1441792
  buffer_load_dwordx4 v13, s[16:19], s46 offen nt lds
  buffer_load_dwordx4 v[52:55], v12, s[20:23], s43 offen offset:320
  s_mov_b32 m0, 54272
  s_add_u32 s46, s60, 1572864
  buffer_load_dwordx4 v13, s[16:19], s46 offen nt lds
  s_mov_b32 m0, 55296
  s_add_u32 s46, s60, 1703936
  buffer_load_dwordx4 v13, s[16:19], s46 offen nt lds
  buffer_load_dwordx4 v[56:59], v12, s[20:23], s43 offen offset:384
  s_mov_b32 m0, 56320
  s_add_u32 s46, s60, 1835008
  buffer_load_dwordx4 v13, s[16:19], s46 offen nt lds
  s_mov_b32 m0, 57344
  s_add_u32 s46, s60, 1966080
  buffer_load_dwordx4 v13, s[16:19], s46 offen nt lds
  buffer_load_dwordx4 v[60:63], v12, s[20:23], s43 offen offset:448
  s_mov_b32 m0, 58368
  s_add_u32 s46, s60, 2097152
  buffer_load_dwordx4 v13, s[16:19], s46 offen nt lds
  s_mov_b32 m0, 59392
  s_add_u32 s46, s60, 2228224
  buffer_load_dwordx4 v13, s[16:19], s46 offen nt lds
  buffer_load_dwordx4 v[64:67], v12, s[20:23], s43 offen offset:512
L_p1:
  s_cmp_lg_u32 s3, 1
  s_cbranch_scc1 L_p2
  v_mov_b32 v32, -1
  v_mov_b32 v33, -1
  v_mov_b32 v34, -1
  v_mov_b32 v35, -1
  s_lshl_b32 s63, s62, 11
  buffer_store_dwordx4 v[32:35], v3, s[32:35], s63 offen sc1
  buffer_store_dwordx4 v[32:35], v3, s[32:35], s63 offen offset:1024 sc1
  v_lshlrev_b32 v15, 3, v1
  s_lshl_b32 s41, s62, 9
  s_add_u32 s41, s41, 1048576
  buffer_store_dwordx2 v[32:33], v15, s[32:35], s41 offen sc1
  s_mov_b32 s56, 1
  s_lshl_b32 s57, s4, 4
  s_waitcnt vmcnt(0)
  s_atomic_add s56, s[76:77], s57
  s_branch L_p3
L_p2:
L_p3:
  buffer_load_dwordx4 a[0:3], v2, s[8:11], s48 offen offset:0 nt
  buffer_load_dwordx4 a[4:7], v2, s[8:11], s48 offen offset:128 nt
  buffer_load_dwordx4 a[8:11], v2, s[8:11], s48 offen offset:2048 nt
  s_add_u32 s12, s68, s40
  s_addc_u32 s13, s69, 0
  s_and_b32 s13, s13, 0xffff
  s_mov_b32 s14, 262144
  s_mov_b32 s15, 0x20000
  s_mov_b32 s24, s72
  s_and_b32 s25, s73, 0xffff
  s_mov_b32 s26, 4718592
  s_mov_b32 s27, 0x20000
  s_mov_b32 s28, s74
  s_and_b32 s29, s75, 0xffff
  s_mov_b32 s30, 18432
  s_mov_b32 s31, 0x20000
  s_mov_b32 s36, s76
  s_and_b32 s37, s77, 0xffff
  s_mov_b32 s38, 256
  s_mov_b32 s39, 0x20000
  s_lshr_b32 s42, s5, 1
  s_sub_u32 s41, s5, 7
  s_cmp_ge_u32 s5, 14
  s_cselect_b32 s42, s41, s42
  s_cselect_b32 s59, 1, 0
  s_lshl_b32 s47, s42, 7
  v_lshrrev_b32 v10, 3, v1
  v_mul_u32_u24 v10, 1152, v10
  v_and_b32 v11, 7, v1
  v_lshl_add_u32 v10, v11, 4, v10
  s_lshl_b32 s7, s3, 12
  s_add_u32 s7, s7, 9216
  s_lshl_b32 s41, s4, 8
  s_lshl_b32 s42, s3, 5
  s_add_u32 s41, s41, s42
  s_mul_i32 s41, s41, 1152
  s_add_u32 s47, s47, s41
  s_cmp_eq_u32 s3, 0
  s_cbranch_scc1 L_w0
  s_cmp_eq_u32 s3, 1
  s_cbranch_scc1 L_w1
  s_waitcnt vmcnt(2)
  buffer_load_dwordx4 a[12:15], v2, s[8:11], s48 offen offset:2176 nt
  s_waitcnt vmcnt(2)
  buffer_load_dwordx4 a[16:19], v2, s[8:11], s49 offen offset:0 nt
  s_waitcnt vmcnt(2)
  buffer_load_dwordx4 a[20:23], v2, s[8:11], s49 offen offset:128 nt
  s_waitcnt vmcnt(2)
  buffer_load_dwordx4 a[24:27], v2, s[8:11], s49 offen offset:2048 nt
  s_waitcnt vmcnt(2)
  buffer_load_dwordx4 a[28:31], v2, s[8:11], s49 offen offset:2176 nt
  s_waitcnt vmcnt(2)
  buffer_load_dwordx4 a[32:35], v2, s[8:11], s50 offen offset:0 nt
  s_mov_b32 m0, s7
  s_nop 0
  buffer_load_dwordx4 v10, s[24:27], s47 offen nt lds
  s_add_u32 s47, s47, 9216
  s_add_u32 s7, s7, 1024
  s_waitcnt vmcnt(3)
  buffer_load_dwordx4 a[36:39], v2, s[8:11], s50 offen offset:128 nt
  s_waitcnt vmcnt(3)
  buffer_load_dwordx4 a[40:43], v2, s[8:11], s50 offen offset:2048 nt
  s_waitcnt vmcnt(3)
  buffer_load_dwordx4 a[44:47], v2, s[8:11], s50 offen offset:2176 nt
  s_mov_b32 m0, s7
  s_nop 0
  buffer_load_dwordx4 v10, s[24:27], s47 offen nt lds
  s_add_u32 s47, s47, 9216
  s_add_u32 s7, s7, 1024
  s_waitcnt vmcnt(3)
  buffer_load_dwordx4 a[48:51], v2, s[8:11], s51 offen offset:0 nt
  s_waitcnt vmcnt(3)
  buffer_load_dwordx4 a[52:55], v2, s[8:11], s51 offen offset:128 nt
  s_waitcnt vmcnt(3)
  buffer_load_dwordx4 a[56:59], v2, s[8:11], s51 offen offset:2048 nt
  s_mov_b32 m0, s7
  s_nop 0
  buffer_load_dwordx4 v10, s[24:27], s47 offen nt lds
  s_add_u32 s47, s47, 9216
  s_add_u32 s7, s7, 1024
  s_waitcnt vmcnt(3)
  buffer_load_dwordx4 a[60:63], v2, s[8:11], s51 offen offset:2176 nt
  s_waitcnt vmcnt(3)
  buffer_load_dwordx4 a[64:67], v2, s[8:11], s52 offen offset:0 nt
  s_waitcnt vmcnt(3)
  buffer_load_dwordx4 a[68:71], v2, s[8:11], s52 offen offset:128 nt
  s_mov_b32 m0, s7
  s_nop 0
  buffer_load_dwordx4 v10, s[24:27], s47 offen nt lds
  s_waitcnt vmcnt(3)
  buffer_load_dwordx4 a[72:75], v2, s[8:11], s52 offen offset:2048 nt
  s_waitcnt vmcnt(3)
  buffer_load_dwordx4 a[76:79], v2, s[8:11], s52 offen offset:2176 nt
  s_waitcnt vmcnt(3)
  buffer_load_dwordx4 a[80:83], v2, s[8:11], s53 offen offset:0 nt
  s_waitcnt vmcnt(2)
  s_waitcnt lgkmcnt(0)
  v_mov_b32 v10, 0
  v_mov_b32 v11, 1
  s_mov_b64 exec, 1
  ds_add_u32 v10, v11 offset:768
  s_mov_b64 exec, -1
  buffer_load_dwordx4 a[84:87], v2, s[8:11], s53 offen offset:128 nt
  s_waitcnt vmcnt(2)
  buffer_load_dwordx4 a[88:91], v2, s[8:11], s53 offen offset:2048 nt
  s_waitcnt vmcnt(2)
  buffer_load_dwordx4 a[92:95], v2, s[8:11], s53 offen offset:2176 nt
  s_waitcnt vmcnt(2)
  buffer_load_dwordx4 a[96:99], v2, s[8:11], s54 offen offset:0 nt
  s_waitcnt vmcnt(2)
  buffer_load_dwordx4 a[100:103], v2, s[8:11], s54 offen offset:128 nt
  s_waitcnt vmcnt(2)
  buffer_load_dwordx4 a[104:107], v2, s[8:11], s54 offen offset:2048 nt
  s_waitcnt vmcnt(2)
  buffer_load_dwordx4 a[108:111], v2, s[8:11], s54 offen offset:2176 nt
  s_waitcnt vmcnt(2)
  buffer_load_dwordx4 a[112:115], v2, s[8:11], s55 offen offset:0 nt
  s_waitcnt vmcnt(2)
  buffer_load_dwordx4 a[116:119], v2, s[8:11], s55 offen offset:128 nt
  s_waitcnt vmcnt(2)
  buffer_load_dwordx4 a[120:123], v2, s[8:11], s55 offen offset:2048 nt
  s_waitcnt vmcnt(2)
  buffer_load_dwordx4 a[124:127], v2, s[8:11], s55 offen offset:2176 nt
L_vfirst:
  s_waitcnt vmcnt(2)
  buffer_load_dwordx4 v[64:67], v3, s[12:15], s48 offen offset:0 nt
  s_waitcnt vmcnt(2)
  buffer_load_dwordx4 v[68:71], v3, s[12:15], s48 offen offset:1024 nt
  v_mov_b32 v6, 0
  s_mov_b32 s46, 2097152
L_ldsw0:
  ds_read_b32 v7, v6 offset:768
  s_waitcnt lgkmcnt(0)
  v_readfirstlane_b32 s42, v7
  s_and_b32 s42, s42, 256
  s_cmp_eq_u32 s42, 256
  s_cbranch_scc1 L_ldsw0_done
  s_sub_u32 s46, s46, 1
  s_cmp_eq_u32 s46, 0
  s_cbranch_scc1 L_ldsw0_done
  s_sleep 1
  s_branch L_ldsw0
L_ldsw0_done:
  v_and_b32 v6, 1, v5
  v_lshlrev_b32 v6, 8, v6
  v_bfe_u32 v7, v5, 1, 1
  v_lshl_add_u32 v6, v7, 6, v6
  v_lshl_add_u32 v6, v4, 4, v6
  ds_read_b128 v[16:19], v6 offset:0
  ds_read_b128 v[20:23], v6 offset:128
  s_waitcnt lgkmcnt(0)
  v_mfma_f32_16x16x32_bf16 v[8:11], a[0:3], v[16:19], 0
  v_mfma_f32_16x16x32_bf16 v[8:11], a[4:7], v[20:23], v[8:11]
  v_mfma_f32_16x16x32_bf16 v[12:15], a[8:11], v[16:19], 0
  v_mfma_f32_16x16x32_bf16 v[12:15], a[12:15], v[20:23], v[12:15]
  v_mfma_f32_16x16x32_bf16 v[24:27], a[16:19], v[16:19], 0
  v_mfma_f32_16x16x32_bf16 v[24:27], a[20:23], v[20:23], v[24:27]
  v_mfma_f32_16x16x32_bf16 v[28:31], a[24:27], v[16:19], 0
  v_mfma_f32_16x16x32_bf16 v[28:31], a[28:31], v[20:23], v[28:31]
  s_nop 1
  v_add_f32_dpp v32, v9, v8 quad_perm:[2,3,0,1] row_mask:0xf bank_mask:0xf
  v_add_f32_dpp v33, v11, v10 quad_perm:[2,3,0,1] row_mask:0xf bank_mask:0xf
  v_add_f32_dpp v34, v13, v12 quad_perm:[2,3,0,1] row_mask:0xf bank_mask:0xf
  v_add_f32_dpp v35, v15, v14 quad_perm:[2,3,0,1] row_mask:0xf bank_mask:0xf
  v_add_f32_dpp v36, v25, v24 quad_perm:[2,3,0,1] row_mask:0xf bank_mask:0xf
  v_add_f32_dpp v37, v27, v26 quad_perm:[2,3,0,1] row_mask:0xf bank_mask:0xf
  v_add_f32_dpp v38, v29, v28 quad_perm:[2,3,0,1] row_mask:0xf bank_mask:0xf
  v_add_f32_dpp v39, v31, v30 quad_perm:[2,3,0,1] row_mask:0xf bank_mask:0xf
  v_mfma_f32_16x16x32_bf16 v[8:11], a[32:35], v[16:19], 0
  v_mfma_f32_16x16x32_bf16 v[8:11], a[36:39], v[20:23], v[8:11]
  v_mfma_f32_16x16x32_bf16 v[12:15], a[40:43], v[16:19], 0
  v_mfma_f32_16x16x32_bf16 v[12:15], a[44:47], v[20:23], v[12:15]
  v_mfma_f32_16x16x32_bf16 v[24:27], a[48:51], v[16:19], 0
  v_mfma_f32_16x16x32_bf16 v[24:27], a[52:55], v[20:23], v[24:27]
  v_mfma_f32_16x16x32_bf16 v[28:31], a[56:59], v[16:19], 0
  v_mfma_f32_16x16x32_bf16 v[28:31], a[60:63], v[20:23], v[28:31]
  s_nop 1
  v_add_f32_dpp v40, v9, v8 quad_perm:[2,3,0,1] row_mask:0xf bank_mask:0xf
  v_add_f32_dpp v41, v11, v10 quad_perm:[2,3,0,1] row_mask:0xf bank_mask:0xf
  v_add_f32_dpp v42, v13, v12 quad_perm:[2,3,0,1] row_mask:0xf bank_mask:0xf
  v_add_f32_dpp v43, v15, v14 quad_perm:[2,3,0,1] row_mask:0xf bank_mask:0xf
  v_add_f32_dpp v44, v25, v24 quad_perm:[2,3,0,1] row_mask:0xf bank_mask:0xf
  v_add_f32_dpp v45, v27, v26 quad_perm:[2,3,0,1] row_mask:0xf bank_mask:0xf
  v_add_f32_dpp v46, v29, v28 quad_perm:[2,3,0,1] row_mask:0xf bank_mask:0xf
  v_add_f32_dpp v47, v31, v30 quad_perm:[2,3,0,1] row_mask:0xf bank_mask:0xf
  s_waitcnt vmcnt(2)
  buffer_load_dwordx4 v[72:75], v3, s[12:15], s48 offen offset:2048 nt
  v_mfma_f32_16x16x32_bf16 v[8:11], a[64:67], v[16:19], 0
  v_mfma_f32_16x16x32_bf16 v[8:11], a[68:71], v[20:23], v[8:11]
  v_mfma_f32_16x16x32_bf16 v[12:15], a[72:75], v[16:19], 0
  v_mfma_f32_16x16x32_bf16 v[12:15], a[76:79], v[20:23], v[12:15]
  v_mfma_f32_16x16x32_bf16 v[24:27], a[80:83], v[16:19], 0
  v_mfma_f32_16x16x32_bf16 v[24:27], a[84:87], v[20:23], v[24:27]
  v_mfma_f32_16x16x32_bf16 v[28:31], a[88:91], v[16:19], 0
  v_mfma_f32_16x16x32_bf16 v[28:31], a[92:95], v[20:23], v[28:31]
  s_nop 1
  v_add_f32_dpp v48, v9, v8 quad_perm:[2,3,0,1] row_mask:0xf bank_mask:0xf
  v_add_f32_dpp v49, v11, v10 quad_perm:[2,3,0,1] row_mask:0xf bank_mask:0xf
  v_add_f32_dpp v50, v13, v12 quad_perm:[2,3,0,1] row_mask:0xf bank_mask:0xf
  v_add_f32_dpp v51, v15, v14 quad_perm:[2,3,0,1] row_mask:0xf bank_mask:0xf
  v_add_f32_dpp v52, v25, v24 quad_perm:[2,3,0,1] row_mask:0xf bank_mask:0xf
  v_add_f32_dpp v53, v27, v26 quad_perm:[2,3,0,1] row_mask:0xf bank_mask:0xf
  v_add_f32_dpp v54, v29, v28 quad_perm:[2,3,0,1] row_mask:0xf bank_mask:0xf
  v_add_f32_dpp v55, v31, v30 quad_perm:[2,3,0,1] row_mask:0xf bank_mask:0xf
  v_mfma_f32_16x16x32_bf16 v[8:11], a[96:99], v[16:19], 0
  v_mfma_f32_16x16x32_bf16 v[8:11], a[100:103], v[20:23], v[8:11]
  v_mfma_f32_16x16x32_bf16 v[12:15], a[104:107], v[16:19], 0
  v_mfma_f32_16x16x32_bf16 v[12:15], a[108:111], v[20:23], v[12:15]
  v_mfma_f32_16x16x32_bf16 v[24:27], a[112:115], v[16:19], 0
  v_mfma_f32_16x16x32_bf16 v[24:27], a[116:119], v[20:23], v[24:27]
  v_mfma_f32_16x16x32_bf16 v[28:31], a[120:123], v[16:19], 0
  v_mfma_f32_16x16x32_bf16 v[28:31], a[124:127], v[20:23], v[28:31]
  s_nop 1
  v_add_f32_dpp v56, v9, v8 quad_perm:[2,3,0,1] row_mask:0xf bank_mask:0xf
  v_add_f32_dpp v57, v11, v10 quad_perm:[2,3,0,1] row_mask:0xf bank_mask:0xf
  v_add_f32_dpp v58, v13, v12 quad_perm:[2,3,0,1] row_mask:0xf bank_mask:0xf
  v_add_f32_dpp v59, v15, v14 quad_perm:[2,3,0,1] row_mask:0xf bank_mask:0xf
  v_add_f32_dpp v60, v25, v24 quad_perm:[2,3,0,1] row_mask:0xf bank_mask:0xf
  v_add_f32_dpp v61, v27, v26 quad_perm:[2,3,0,1] row_mask:0xf bank_mask:0xf
  v_add_f32_dpp v62, v29, v28 quad_perm:[2,3,0,1] row_mask:0xf bank_mask:0xf
  v_add_f32_dpp v63, v31, v30 quad_perm:[2,3,0,1] row_mask:0xf bank_mask:0xf
  s_waitcnt vmcnt(2)
  buffer_load_dwordx4 v[76:79], v3, s[12:15], s48 offen offset:3072 nt
  s_mov_b32 s40, 0x3db504f3
  s_mov_b32 s41, 0x3fb8aa3b
  s_mov_b32 s42, 0xffff0000
  v_cvt_pk_bf16_f32 v16, v32, v33
  v_lshlrev_b32 v32, 16, v16
  v_and_b32 v33, s42, v16
  v_mul_f32 v32, s40, v32
  v_mul_f32 v33, s40, v33
  v_cvt_pk_bf16_f32 v16, v32, v33
  v_lshlrev_b32 v32, 16, v16
  v_and_b32 v33, s42, v16
  v_cvt_pk_bf16_f32 v17, v34, v35
  v_lshlrev_b32 v34, 16, v17
  v_and_b32 v35, s42, v17
  v_mul_f32 v34, s40, v34
  v_mul_f32 v35, s40, v35
  v_cvt_pk_bf16_f32 v17, v34, v35
  v_lshlrev_b32 v34, 16, v17
  v_and_b32 v35, s42, v17
  v_cvt_pk_bf16_f32 v18, v36, v37
  v_lshlrev_b32 v36, 16, v18
  v_and_b32 v37, s42, v18
  v_mul_f32 v36, s40, v36
  v_mul_f32 v37, s40, v37
  v_cvt_pk_bf16_f32 v18, v36, v37
  v_lshlrev_b32 v36, 16, v18
  v_and_b32 v37, s42, v18
  v_cvt_pk_bf16_f32 v19, v38, v39
  v_lshlrev_b32 v38, 16, v19
  v_and_b32 v39, s42, v19
  v_mul_f32 v38, s40, v38
  v_mul_f32 v39, s40, v39
  v_cvt_pk_bf16_f32 v19, v38, v39
  v_lshlrev_b32 v38, 16, v19
  v_and_b32 v39, s42, v19
  v_cvt_pk_bf16_f32 v20, v40, v41
  v_lshlrev_b32 v40, 16, v20
  v_and_b32 v41, s42, v20
  v_mul_f32 v40, s40, v40
  v_mul_f32 v41, s40, v41
  v_cvt_pk_bf16_f32 v20, v40, v41
  v_lshlrev_b32 v40, 16, v20
  v_and_b32 v41, s42, v20
  v_cvt_pk_bf16_f32 v21, v42, v43
  v_lshlrev_b32 v42, 16, v21
  v_and_b32 v43, s42, v21
  v_mul_f32 v42, s40, v42
  v_mul_f32 v43, s40, v43
  v_cvt_pk_bf16_f32 v21, v42, v43
  v_lshlrev_b32 v42, 16, v21
  v_and_b32 v43, s42, v21
  v_cvt_pk_bf16_f32 v22, v44, v45
  v_lshlrev_b32 v44, 16, v22
  v_and_b32 v45, s42, v22
  v_mul_f32 v44, s40, v44
  v_mul_f32 v45, s40, v45
  v_cvt_pk_bf16_f32 v22, v44, v45
  v_lshlrev_b32 v44, 16, v22
  v_and_b32 v45, s42, v22
  v_cvt_pk_bf16_f32 v23, v46, v47
  v_lshlrev_b32 v46, 16, v23
  v_and_b32 v47, s42, v23
  v_mul_f32 v46, s40, v46
  v_mul_f32 v47, s40, v47
  v_cvt_pk_bf16_f32 v23, v46, v47
  v_lshlrev_b32 v46, 16, v23
  v_and_b32 v47, s42, v23
  s_waitcnt vmcnt(2)
  buffer_load_dwordx4 v[80:83], v3, s[12:15], s49 offen offset:0 nt
  v_cvt_pk_bf16_f32 v16, v48, v49
  v_lshlrev_b32 v48, 16, v16
  v_and_b32 v49, s42, v16
  v_mul_f32 v48, s40, v48
  v_mul_f32 v49, s40, v49
  v_cvt_pk_bf16_f32 v16, v48, v49
  v_lshlrev_b32 v48, 16, v16
  v_and_b32 v49, s42, v16
  v_cvt_pk_bf16_f32 v17, v50, v51
  v_lshlrev_b32 v50, 16, v17
  v_and_b32 v51, s42, v17
  v_mul_f32 v50, s40, v50
  v_mul_f32 v51, s40, v51
  v_cvt_pk_bf16_f32 v17, v50, v51
  v_lshlrev_b32 v50, 16, v17
  v_and_b32 v51, s42, v17
  v_cvt_pk_bf16_f32 v18, v52, v53
  v_lshlrev_b32 v52, 16, v18
  v_and_b32 v53, s42, v18
  v_mul_f32 v52, s40, v52
  v_mul_f32 v53, s40, v53
  v_cvt_pk_bf16_f32 v18, v52, v53
  v_lshlrev_b32 v52, 16, v18
  v_and_b32 v53, s42, v18
  v_cvt_pk_bf16_f32 v19, v54, v55
  v_lshlrev_b32 v54, 16, v19
  v_and_b32 v55, s42, v19
  v_mul_f32 v54, s40, v54
  v_mul_f32 v55, s40, v55
  v_cvt_pk_bf16_f32 v19, v54, v55
  v_lshlrev_b32 v54, 16, v19
  v_and_b32 v55, s42, v19
  v_cvt_pk_bf16_f32 v20, v56, v57
  v_lshlrev_b32 v56, 16, v20
  v_and_b32 v57, s42, v20
  v_mul_f32 v56, s40, v56
  v_mul_f32 v57, s40, v57
  v_cvt_pk_bf16_f32 v20, v56, v57
  v_lshlrev_b32 v56, 16, v20
  v_and_b32 v57, s42, v20
  v_cvt_pk_bf16_f32 v21, v58, v59
  v_lshlrev_b32 v58, 16, v21
  v_and_b32 v59, s42, v21
  v_mul_f32 v58, s40, v58
  v_mul_f32 v59, s40, v59
  v_cvt_pk_bf16_f32 v21, v58, v59
  v_lshlrev_b32 v58, 16, v21
  v_and_b32 v59, s42, v21
  v_cvt_pk_bf16_f32 v22, v60, v61
  v_lshlrev_b32 v60, 16, v22
  v_and_b32 v61, s42, v22
  v_mul_f32 v60, s40, v60
  v_mul_f32 v61, s40, v61
  v_cvt_pk_bf16_f32 v22, v60, v61
  v_lshlrev_b32 v60, 16, v22
  v_and_b32 v61, s42, v22
  v_cvt_pk_bf16_f32 v23, v62, v63
  v_lshlrev_b32 v62, 16, v23
  v_and_b32 v63, s42, v23
  v_mul_f32 v62, s40, v62
  v_mul_f32 v63, s40, v63
  v_cvt_pk_bf16_f32 v23, v62, v63
  v_lshlrev_b32 v62, 16, v23
  v_and_b32 v63, s42, v23
  s_waitcnt vmcnt(2)
  buffer_load_dwordx4 v[84:87], v3, s[12:15], s49 offen offset:1024 nt
  v_max3_f32 v6, v32, v33, v34
  v_max3_f32 v6, v6, v35, v36
  v_max3_f32 v6, v6, v37, v38
  v_max3_f32 v6, v6, v39, v40
  v_max3_f32 v6, v6, v41, v42
  v_max3_f32 v6, v6, v43, v44
  v_max3_f32 v6, v6, v45, v46
  v_max3_f32 v6, v6, v47, v48
  v_max3_f32 v6, v6, v49, v50
  v_max3_f32 v6, v6, v51, v52
  v_max3_f32 v6, v6, v53, v54
  v_max3_f32 v6, v6, v55, v56
  v_max3_f32 v6, v6, v57, v58
  v_max3_f32 v6, v6, v59, v60
  v_max3_f32 v6, v6, v61, v62
  v_max_f32 v6, v6, v63
  v_mov_b32 v7, v6
  s_nop 1
  v_permlane32_swap_b32 v6, v7
  s_nop 1
  v_max_f32 v6, v6, v7
  v_mov_b32 v7, v6
  s_nop 1
  v_permlane16_swap_b32 v6, v7
  s_nop 1
  v_max_f32 v6, v6, v7
  s_waitcnt vmcnt(2)
  buffer_load_dwordx4 v[88:91], v3, s[12:15], s49 offen offset:2048 nt
  v_mul_f32 v7, s41, v6
  v_fma_f32 v32, v32, s41, -v7
  v_fma_f32 v33, v33, s41, -v7
  v_fma_f32 v34, v34, s41, -v7
  v_fma_f32 v35, v35, s41, -v7
  v_fma_f32 v36, v36, s41, -v7
  v_fma_f32 v37, v37, s41, -v7
  v_fma_f32 v38, v38, s41, -v7
  v_fma_f32 v39, v39, s41, -v7
  v_fma_f32 v40, v40, s41, -v7
  v_fma_f32 v41, v41, s41, -v7
  v_fma_f32 v42, v42, s41, -v7
  v_fma_f32 v43, v43, s41, -v7
  v_fma_f32 v44, v44, s41, -v7
  v_fma_f32 v45, v45, s41, -v7
  v_fma_f32 v46, v46, s41, -v7
  v_fma_f32 v47, v47, s41, -v7
  v_fma_f32 v48, v48, s41, -v7
  v_fma_f32 v49, v49, s41, -v7
  v_fma_f32 v50, v50, s41, -v7
  v_fma_f32 v51, v51, s41, -v7
  v_fma_f32 v52, v52, s41, -v7
  v_fma_f32 v53, v53, s41, -v7
  v_fma_f32 v54, v54, s41, -v7
  v_fma_f32 v55, v55, s41, -v7
  v_fma_f32 v56, v56, s41, -v7
  v_fma_f32 v57, v57, s41, -v7
  v_fma_f32 v58, v58, s41, -v7
  v_fma_f32 v59, v59, s41, -v7
  v_fma_f32 v60, v60, s41, -v7
  v_fma_f32 v61, v61, s41, -v7
  v_fma_f32 v62, v62, s41, -v7
  v_fma_f32 v63, v63, s41, -v7
  v_exp_f32 v32, v32
  v_exp_f32 v33, v33
  v_exp_f32 v34, v34
  v_exp_f32 v35, v35
  v_exp_f32 v36, v36
  v_exp_f32 v37, v37
  v_exp_f32 v38, v38
  v_exp_f32 v39, v39
  v_exp_f32 v40, v40
  v_exp_f32 v41, v41
  v_exp_f32 v42, v42
  v_exp_f32 v43, v43
  v_exp_f32 v44, v44
  v_exp_f32 v45, v45
  v_exp_f32 v46, v46
  v_exp_f32 v47, v47
  v_exp_f32 v48, v48
  v_exp_f32 v49, v49
  v_exp_f32 v50, v50
  v_exp_f32 v51, v51
  v_exp_f32 v52, v52
  v_exp_f32 v53, v53
  v_exp_f32 v54, v54
  v_exp_f32 v55, v55
  v_exp_f32 v56, v56
  v_exp_f32 v57, v57
  v_exp_f32 v58, v58
  v_exp_f32 v59, v59
  v_exp_f32 v60, v60
  v_exp_f32 v61, v61
  v_exp_f32 v62, v62
  v_exp_f32 v63, v63
  s_waitcnt vmcnt(2)
  buffer_load_dwordx4 v[92:95], v3, s[12:15], s49 offen offset:3072 nt
  s_nop 0
  v_add_f32 v8, v32, v33
  v_add_f32 v9, v34, v35
  v_add_f32 v8, v8, v36
  v_add_f32 v9, v9, v37
  v_add_f32 v8, v8, v38
  v_add_f32 v9, v9, v39
  v_add_f32 v8, v8, v40
  v_add_f32 v9, v9, v41
  v_add_f32 v8, v8, v42
  v_add_f32 v9, v9, v43
  v_add_f32 v8, v8, v44
  v_add_f32 v9, v9, v45
  v_add_f32 v8, v8, v46
  v_add_f32 v9, v9, v47
  v_add_f32 v8, v8, v48
  v_add_f32 v9, v9, v49
  v_add_f32 v8, v8, v50
  v_add_f32 v9, v9, v51
  v_add_f32 v8, v8, v52
  v_add_f32 v9, v9, v53
  v_add_f32 v8, v8, v54
  v_add_f32 v9, v9, v55
  v_add_f32 v8, v8, v56
  v_add_f32 v9, v9, v57
  v_add_f32 v8, v8, v58
  v_add_f32 v9, v9, v59
  v_add_f32 v8, v8, v60
  v_add_f32 v9, v9, v61
  v_add_f32 v8, v8, v62
  v_add_f32 v9, v9, v63
  v_add_f32 v8, v8, v9
  v_mov_b32 v9, v8
  s_nop 1
  v_permlane32_swap_b32 v8, v9
  s_nop 1
  v_add_f32 v8, v8, v9
  v_mov_b32 v9, v8
  s_nop 1
  v_permlane16_swap_b32 v8, v9
  s_nop 1
  v_add_f32 v8, v8, v9
  v_mov_b32 v10, v7
  v_mov_b32 v11, v8
  v_and_b32 v12, 1, v5
  v_lshlrev_b32 v12, 6, v12
  s_lshl_b32 s42, s3, 3
  v_add_u32 v13, s42, v12
  s_mov_b64 exec, 3
  ds_write_b64 v13, v[10:11] offset:512
  s_mov_b64 exec, -1
  s_waitcnt lgkmcnt(0)
  v_mov_b32 v10, 0
  v_mov_b32 v11, 65536
  s_mov_b64 exec, 1
  ds_add_u32 v10, v11 offset:768
  s_mov_b64 exec, -1
  s_waitcnt vmcnt(2)
  buffer_load_dwordx4 v[96:99], v3, s[12:15], s50 offen offset:0 nt
  s_waitcnt vmcnt(2)
  buffer_load_dwordx4 v[100:103], v3, s[12:15], s50 offen offset:1024 nt
  s_waitcnt vmcnt(2)
  buffer_load_dwordx4 v[104:107], v3, s[12:15], s50 offen offset:2048 nt
  s_waitcnt vmcnt(2)
  buffer_load_dwordx4 v[108:111], v3, s[12:15], s50 offen offset:3072 nt
  s_waitcnt vmcnt(2)
  buffer_load_dwordx4 v[112:115], v3, s[12:15], s51 offen offset:0 nt
  s_waitcnt vmcnt(2)
  buffer_load_dwordx4 v[116:119], v3, s[12:15], s51 offen offset:1024 nt
  s_waitcnt vmcnt(2)
  buffer_load_dwordx4 v[120:123], v3, s[12:15], s51 offen offset:2048 nt
  s_waitcnt vmcnt(2)
  buffer_load_dwordx4 v[124:127], v3, s[12:15], s51 offen offset:3072 nt
  v_mov_b32 v10, 0
  s_mov_b32 s46, 2097152
L_ldsw1:
  ds_read_b32 v11, v10 offset:768
  s_waitcnt lgkmcnt(0)
  v_readfirstlane_b32 s42, v11
  s_and_b32 s42, s42, 16711680
  s_cmp_eq_u32 s42, 524288
  s_cbranch_scc1 L_ldsw1_done
  s_sub_u32 s46, s46, 1
  s_cmp_eq_u32 s46, 0
  s_cbranch_scc1 L_ldsw1_done
  s_sleep 1
  s_branch L_ldsw1
L_ldsw1_done:
  ds_read_b128 v[16:19], v12 offset:512
  ds_read_b128 v[20:23], v12 offset:528
  ds_read_b128 v[24:27], v12 offset:544
  ds_read_b128 v[28:31], v12 offset:560
  s_waitcnt lgkmcnt(0)
  v_max3_f32 v10, v16, v18, v20
  v_max3_f32 v10, v10, v22, v24
  v_max3_f32 v10, v10, v26, v28
  v_max_f32 v10, v10, v30
  v_sub_f32 v16, v16, v10
  v_sub_f32 v18, v18, v10
  v_sub_f32 v20, v20, v10
  v_sub_f32 v22, v22, v10
  v_sub_f32 v24, v24, v10
  v_sub_f32 v26, v26, v10
  v_sub_f32 v28, v28, v10
  v_sub_f32 v30, v30, v10
  v_exp_f32 v16, v16
  v_exp_f32 v18, v18
  v_exp_f32 v20, v20
  v_exp_f32 v22, v22
  v_exp_f32 v24, v24
  v_exp_f32 v26, v26
  v_exp_f32 v28, v28
  v_exp_f32 v30, v30
  v_sub_f32 v7, v7, v10
  v_exp_f32 v7, v7
  v_mul_f32 v8, v16, v17
  v_fmac_f32 v8, v18, v19
  v_fmac_f32 v8, v20, v21
  v_fmac_f32 v8, v22, v23
  v_fmac_f32 v8, v24, v25
  v_fmac_f32 v8, v26, v27
  v_fmac_f32 v8, v28, v29
  v_fmac_f32 v8, v30, v31
  v_rcp_f32 v8, v8
  s_nop 0
  v_mul_f32 v7, v7, v8
  v_mul_f32 v32, v32, v7
  v_mul_f32 v33, v33, v7
  v_mul_f32 v34, v34, v7
  v_mul_f32 v35, v35, v7
  v_mul_f32 v36, v36, v7
  v_mul_f32 v37, v37, v7
  v_mul_f32 v38, v38, v7
  v_mul_f32 v39, v39, v7
  v_mul_f32 v40, v40, v7
  v_mul_f32 v41, v41, v7
  v_mul_f32 v42, v42, v7
  v_mul_f32 v43, v43, v7
  v_mul_f32 v44, v44, v7
  v_mul_f32 v45, v45, v7
  v_mul_f32 v46, v46, v7
  v_mul_f32 v47, v47, v7
  v_mul_f32 v48, v48, v7
  v_mul_f32 v49, v49, v7
  v_mul_f32 v50, v50, v7
  v_mul_f32 v51, v51, v7
  v_mul_f32 v52, v52, v7
  v_mul_f32 v53, v53, v7
  v_mul_f32 v54, v54, v7
  v_mul_f32 v55, v55, v7
  v_mul_f32 v56, v56, v7
  v_mul_f32 v57, v57, v7
  v_mul_f32 v58, v58, v7
  v_mul_f32 v59, v59, v7
  v_mul_f32 v60, v60, v7
  v_mul_f32 v61, v61, v7
  v_mul_f32 v62, v62, v7
  v_mul_f32 v63, v63, v7
  v_cvt_pk_bf16_f32 v32, v32, v33
  v_cvt_pk_bf16_f32 v33, v34, v35
  v_cvt_pk_bf16_f32 v34, v36, v37
  v_cvt_pk_bf16_f32 v35, v38, v39
  v_cvt_pk_bf16_f32 v36, v40, v41
  v_cvt_pk_bf16_f32 v37, v42, v43
  v_cvt_pk_bf16_f32 v38, v44, v45
  v_cvt_pk_bf16_f32 v39, v46, v47
  v_cvt_pk_bf16_f32 v40, v48, v49
  v_cvt_pk_bf16_f32 v41, v50, v51
  v_cvt_pk_bf16_f32 v42, v52, v53
  v_cvt_pk_bf16_f32 v43, v54, v55
  v_cvt_pk_bf16_f32 v44, v56, v57
  v_cvt_pk_bf16_f32 v45, v58, v59
  v_cvt_pk_bf16_f32 v46, v60, v61
  v_cvt_pk_bf16_f32 v47, v62, v63
  v_perm_b32 v16, v68, v64, s44
  v_perm_b32 v20, v68, v64, s45
  v_perm_b32 v17, v76, v72, s44
  v_perm_b32 v21, v76, v72, s45
  v_perm_b32 v18, v84, v80, s44
  v_perm_b32 v22, v84, v80, s45
  v_perm_b32 v19, v92, v88, s44
  v_perm_b32 v23, v92, v88, s45
  s_nop 1
  v_mfma_f32_16x16x32_bf16 a[0:3], v[16:19], v[32:35], 0
  v_mfma_f32_16x16x32_bf16 a[4:7], v[20:23], v[32:35], 0
  v_perm_b32 v24, v69, v65, s44
  v_perm_b32 v28, v69, v65, s45
  v_perm_b32 v25, v77, v73, s44
  v_perm_b32 v29, v77, v73, s45
  v_perm_b32 v26, v85, v81, s44
  v_perm_b32 v30, v85, v81, s45
  v_perm_b32 v27, v93, v89, s44
  v_perm_b32 v31, v93, v89, s45
  s_nop 1
  v_mfma_f32_16x16x32_bf16 a[8:11], v[24:27], v[32:35], 0
  v_mfma_f32_16x16x32_bf16 a[12:15], v[28:31], v[32:35], 0
  v_perm_b32 v16, v70, v66, s44
  v_perm_b32 v20, v70, v66, s45
  v_perm_b32 v17, v78, v74, s44
  v_perm_b32 v21, v78, v74, s45
  v_perm_b32 v18, v86, v82, s44
  v_perm_b32 v22, v86, v82, s45
  v_perm_b32 v19, v94, v90, s44
  v_perm_b32 v23, v94, v90, s45
  s_nop 1
  v_mfma_f32_16x16x32_bf16 a[16:19], v[16:19], v[32:35], 0
  v_mfma_f32_16x16x32_bf16 a[20:23], v[20:23], v[32:35], 0
  v_perm_b32 v24, v71, v67, s44
  v_perm_b32 v28, v71, v67, s45
  v_perm_b32 v25, v79, v75, s44
  v_perm_b32 v29, v79, v75, s45
  v_perm_b32 v26, v87, v83, s44
  v_perm_b32 v30, v87, v83, s45
  v_perm_b32 v27, v95, v91, s44
  v_perm_b32 v31, v95, v91, s45
  s_nop 1
  v_mfma_f32_16x16x32_bf16 a[24:27], v[24:27], v[32:35], 0
  v_mfma_f32_16x16x32_bf16 a[28:31], v[28:31], v[32:35], 0
  s_waitcnt vmcnt(2)
  buffer_load_dwordx4 v[64:67], v3, s[12:15], s52 offen offset:0 nt
  s_waitcnt vmcnt(2)
  buffer_load_dwordx4 v[68:71], v3, s[12:15], s52 offen offset:1024 nt
  s_waitcnt vmcnt(2)
  v_perm_b32 v16, v100, v96, s44
  v_perm_b32 v20, v100, v96, s45
  v_perm_b32 v17, v108, v104, s44
  v_perm_b32 v21, v108, v104, s45
  v_perm_b32 v18, v116, v112, s44
  v_perm_b32 v22, v116, v112, s45
  v_perm_b32 v19, v124, v120, s44
  v_perm_b32 v23, v124, v120, s45
  s_nop 1
  v_mfma_f32_16x16x32_bf16 a[0:3], v[16:19], v[36:39], a[0:3]
  v_mfma_f32_16x16x32_bf16 a[4:7], v[20:23], v[36:39], a[4:7]
  v_perm_b32 v24, v101, v97, s44
  v_perm_b32 v28, v101, v97, s45
  v_perm_b32 v25, v109, v105, s44
  v_perm_b32 v29, v109, v105, s45
  v_perm_b32 v26, v117, v113, s44
  v_perm_b32 v30, v117, v113, s45
  v_perm_b32 v27, v125, v121, s44
  v_perm_b32 v31, v125, v121, s45
  s_nop 1
  v_mfma_f32_16x16x32_bf16 a[8:11], v[24:27], v[36:39], a[8:11]
  v_mfma_f32_16x16x32_bf16 a[12:15], v[28:31], v[36:39], a[12:15]
  v_perm_b32 v16, v102, v98, s44
  v_perm_b32 v20, v102, v98, s45
  v_perm_b32 v17, v110, v106, s44
  v_perm_b32 v21, v110, v106, s45
  v_perm_b32 v18, v118, v114, s44
  v_perm_b32 v22, v118, v114, s45
  v_perm_b32 v19, v126, v122, s44
  v_perm_b32 v23, v126, v122, s45
  s_nop 1
  v_mfma_f32_16x16x32_bf16 a[16:19], v[16:19], v[36:39], a[16:19]
  v_mfma_f32_16x16x32_bf16 a[20:23], v[20:23], v[36:39], a[20:23]
  v_perm_b32 v24, v103, v99, s44
  v_perm_b32 v28, v103, v99, s45
  v_perm_b32 v25, v111, v107, s44
  v_perm_b32 v29, v111, v107, s45
  v_perm_b32 v26, v119, v115, s44
  v_perm_b32 v30, v119, v115, s45
  v_perm_b32 v27, v127, v123, s44
  v_perm_b32 v31, v127, v123, s45
  s_nop 1
  v_mfma_f32_16x16x32_bf16 a[24:27], v[24:27], v[36:39], a[24:27]
  v_mfma_f32_16x16x32_bf16 a[28:31], v[28:31], v[36:39], a[28:31]
  s_cmp_lg_u32 s3, 0
  s_cbranch_scc1 L_b1
  v_mov_b32 v10, 0
  s_mov_b32 s46, 2097152
L_ldsw2:
  ds_read_b32 v11, v10 offset:768
  s_waitcnt lgkmcnt(0)
  v_readfirstlane_b32 s42, v11
  s_and_b32 s42, s42, 255
  s_cmp_eq_u32 s42, 8
  s_cbranch_scc1 L_ldsw2_done
  s_sub_u32 s46, s46, 1
  s_cmp_eq_u32 s46, 0
  s_cbranch_scc1 L_ldsw2_done
  s_sleep 1
  s_branch L_ldsw2
L_ldsw2_done:
  v_and_b32 v10, 1, v4
  v_lshlrev_b32 v10, 6, v10
  v_lshrrev_b32 v11, 1, v4
  v_add_u32 v10, v10, v11
  v_lshrrev_b32 v11, 2, v5
  v_lshl_add_u32 v10, v11, 3, v10
  v_lshlrev_b32 v10, 7, v10
  v_and_b32 v11, 3, v5
  v_lshl_add_u32 v10, v11, 3, v10
  s_and_b32 s42, s5, 1
  s_lshl_b32 s42, s42, 6
  s_cmp_eq_u32 s59, 1
  s_cselect_b32 s42, 0, s42
  v_add_u32 v15, s42, v10
  ds_read_b64_tr_b16 a[32:33], v15 offset:9216
  ds_read_b64_tr_b16 a[34:35], v15 offset:13312
  ds_read_b64_tr_b16 a[36:37], v15 offset:9472
  ds_read_b64_tr_b16 a[38:39], v15 offset:13568
  ds_read_b64_tr_b16 a[40:41], v15 offset:9728
  ds_read_b64_tr_b16 a[42:43], v15 offset:13824
  ds_read_b64_tr_b16 a[44:45], v15 offset:9984
  ds_read_b64_tr_b16 a[46:47], v15 offset:14080
  s_waitcnt lgkmcnt(0)
  ds_read_b64_tr_b16 a[48:49], v15 offset:25600
  ds_read_b64_tr_b16 a[50:51], v15 offset:29696
  ds_read_b64_tr_b16 a[52:53], v15 offset:25856
  ds_read_b64_tr_b16 a[54:55], v15 offset:29952
  ds_read_b64_tr_b16 a[56:57], v15 offset:26112
  ds_read_b64_tr_b16 a[58:59], v15 offset:30208
  ds_read_b64_tr_b16 a[60:61], v15 offset:26368
  ds_read_b64_tr_b16 a[62:63], v15 offset:30464
  s_waitcnt lgkmcnt(0)
  ds_read_b64_tr_b16 a[64:65], v15 offset:9248
  ds_read_b64_tr_b16 a[66:67], v15 offset:13344
  ds_read_b64_tr_b16 a[68:69], v15 offset:9504
  ds_read_b64_tr_b16 a[70:71], v15 offset:13600
  ds_read_b64_tr_b16 a[72:73], v15 offset:9760
  ds_read_b64_tr_b16 a[74:75], v15 offset:13856
  ds_read_b64_tr_b16 a[76:77], v15 offset:10016
  ds_read_b64_tr_b16 a[78:79], v15 offset:14112
  s_waitcnt lgkmcnt(0)
  ds_read_b64_tr_b16 a[80:81], v15 offset:25632
  ds_read_b64_tr_b16 a[82:83], v15 offset:29728
  ds_read_b64_tr_b16 a[84:85], v15 offset:25888
  ds_read_b64_tr_b16 a[86:87], v15 offset:29984
  ds_read_b64_tr_b16 a[88:89], v15 offset:26144
  ds_read_b64_tr_b16 a[90:91], v15 offset:30240
  ds_read_b64_tr_b16 a[92:93], v15 offset:26400
  ds_read_b64_tr_b16 a[94:95], v15 offset:30496
  s_waitcnt lgkmcnt(0)
  s_cmp_eq_u32 s59, 0
  s_cbranch_scc1 L_b1
  ds_read_b64_tr_b16 a[96:97], v15 offset:9280
  ds_read_b64_tr_b16 a[98:99], v15 offset:13376
  ds_read_b64_tr_b16 a[100:101], v15 offset:9536
  ds_read_b64_tr_b16 a[102:103], v15 offset:13632
  ds_read_b64_tr_b16 a[104:105], v15 offset:9792
  ds_read_b64_tr_b16 a[106:107], v15 offset:13888
  ds_read_b64_tr_b16 a[108:109], v15 offset:10048
  ds_read_b64_tr_b16 a[110:111], v15 offset:14144
  s_waitcnt lgkmcnt(0)
  ds_read_b64_tr_b16 a[112:113], v15 offset:25664
  ds_read_b64_tr_b16 a[114:115], v15 offset:29760
  ds_read_b64_tr_b16 a[116:117], v15 offset:25920
  ds_read_b64_tr_b16 a[118:119], v15 offset:30016
  ds_read_b64_tr_b16 a[120:121], v15 offset:26176
  ds_read_b64_tr_b16 a[122:123], v15 offset:30272
  ds_read_b64_tr_b16 a[124:125], v15 offset:26432
  ds_read_b64_tr_b16 a[126:127], v15 offset:30528
  s_waitcnt lgkmcnt(0)
L_b1:
  buffer_load_dwordx4 v[72:75], v3, s[12:15], s52 offen offset:2048 nt
  s_waitcnt vmcnt(2)
  buffer_load_dwordx4 v[76:79], v3, s[12:15], s52 offen offset:3072 nt
  s_waitcnt vmcnt(2)
  buffer_load_dwordx4 v[80:83], v3, s[12:15], s53 offen offset:0 nt
  s_waitcnt vmcnt(2)
  buffer_load_dwordx4 v[84:87], v3, s[12:15], s53 offen offset:1024 nt
  s_waitcnt vmcnt(2)
  buffer_load_dwordx4 v[88:91], v3, s[12:15], s53 offen offset:2048 nt
  s_waitcnt vmcnt(2)
  buffer_load_dwordx4 v[92:95], v3, s[12:15], s53 offen offset:3072 nt
  s_waitcnt vmcnt(2)
  buffer_load_dwordx4 v[96:99], v3, s[12:15], s54 offen offset:0 nt
  s_waitcnt vmcnt(2)
  buffer_load_dwordx4 v[100:103], v3, s[12:15], s54 offen offset:1024 nt
  buffer_load_dwordx4 v[104:107], v3, s[12:15], s54 offen offset:2048 nt
  buffer_load_dwordx4 v[108:111], v3, s[12:15], s54 offen offset:3072 nt
  buffer_load_dwordx4 v[112:115], v3, s[12:15], s55 offen offset:0 nt
  buffer_load_dwordx4 v[116:119], v3, s[12:15], s55 offen offset:1024 nt
  buffer_load_dwordx4 v[120:123], v3, s[12:15], s55 offen offset:2048 nt
  s_waitcnt vmcnt(7)
  buffer_load_dwordx4 v[124:127], v3, s[12:15], s55 offen offset:3072 nt
L_b2:
  v_lshlrev_b32 v6, 3, v1
  s_lshl_b32 s41, s4, 13
  s_add_u32 s41, s41, 1048576
  s_lshl_b32 s60, s5, 9
  s_add_u32 s60, s60, s41
  v_lshlrev_b32 v7, 9, v5
  v_lshl_add_u32 v7, v4, 4, v7
  v_lshlrev_b32 v8, 12, v5
  v_lshl_add_u32 v8, v4, 4, v8
  s_lshl_b32 s43, s5, 16
  s_lshl_b32 s62, s4, 8
  s_add_u32 s43, s43, s62
  s_add_u32 s43, s43, 1179648
  s_lshl_b32 s40, s4, 16
  s_lshl_b32 s62, s5, 12
  s_add_u32 s40, s40, s62
  s_add_u32 s40, s40, 1179648
  v_lshlrev_b32 v9, 2, v1
  s_lshl_b32 s63, s4, 6
  s_lshl_b32 s62, s4, 7
  s_sub_u32 s62, s62, 896
  s_cmp_ge_u32 s4, 14
  s_cselect_b32 s63, s62, s63
  s_cselect_b32 s47, -1, 0
  s_mul_i32 s62, s5, 1152
  s_add_u32 s63, s63, s62
  v_lshlrev_b32 v11, 1, v1
  s_lshl_b32 s42, s3, 10
  v_add_u32 v12, s42, v7
  v_perm_b32 v16, v68, v64, s44
  v_perm_b32 v20, v68, v64, s45
  v_perm_b32 v17, v76, v72, s44
  v_perm_b32 v21, v76, v72, s45
  v_perm_b32 v18, v84, v80, s44
  v_perm_b32 v22, v84, v80, s45
  v_perm_b32 v19, v92, v88, s44
  v_perm_b32 v23, v92, v88, s45
  s_nop 1
  v_mfma_f32_16x16x32_bf16 a[0:3], v[16:19], v[40:43], a[0:3]
  v_mfma_f32_16x16x32_bf16 a[4:7], v[20:23], v[40:43], a[4:7]
  v_perm_b32 v24, v69, v65, s44
  v_perm_b32 v28, v69, v65, s45
  v_perm_b32 v25, v77, v73, s44
  v_perm_b32 v29, v77, v73, s45
  v_perm_b32 v26, v85, v81, s44
  v_perm_b32 v30, v85, v81, s45
  v_perm_b32 v27, v93, v89, s44
  v_perm_b32 v31, v93, v89, s45
  s_nop 1
  v_mfma_f32_16x16x32_bf16 a[8:11], v[24:27], v[40:43], a[8:11]
  v_mfma_f32_16x16x32_bf16 a[12:15], v[28:31], v[40:43], a[12:15]
  v_perm_b32 v16, v70, v66, s44
  v_perm_b32 v20, v70, v66, s45
  v_perm_b32 v17, v78, v74, s44
  v_perm_b32 v21, v78, v74, s45
  v_perm_b32 v18, v86, v82, s44
  v_perm_b32 v22, v86, v82, s45
  v_perm_b32 v19, v94, v90, s44
  v_perm_b32 v23, v94, v90, s45
  s_nop 1
  v_mfma_f32_16x16x32_bf16 a[16:19], v[16:19], v[40:43], a[16:19]
  v_mfma_f32_16x16x32_bf16 a[20:23], v[20:23], v[40:43], a[20:23]
  v_perm_b32 v24, v71, v67, s44
  v_perm_b32 v28, v71, v67, s45
  v_perm_b32 v25, v79, v75, s44
  v_perm_b32 v29, v79, v75, s45
  v_perm_b32 v26, v87, v83, s44
  v_perm_b32 v30, v87, v83, s45
  v_perm_b32 v27, v95, v91, s44
  v_perm_b32 v31, v95, v91, s45
  s_nop 1
  v_mfma_f32_16x16x32_bf16 a[24:27], v[24:27], v[40:43], a[24:27]
  v_mfma_f32_16x16x32_bf16 a[28:31], v[28:31], v[40:43], a[28:31]
  s_waitcnt vmcnt(0)
  v_perm_b32 v16, v100, v96, s44
  v_perm_b32 v20, v100, v96, s45
  v_perm_b32 v17, v108, v104, s44
  v_perm_b32 v21, v108, v104, s45
  v_perm_b32 v18, v116, v112, s44
  v_perm_b32 v22, v116, v112, s45
  v_perm_b32 v19, v124, v120, s44
  v_perm_b32 v23, v124, v120, s45
  s_nop 1
  v_mfma_f32_16x16x32_bf16 a[0:3], v[16:19], v[44:47], a[0:3]
  v_mfma_f32_16x16x32_bf16 a[4:7], v[20:23], v[44:47], a[4:7]
  v_perm_b32 v24, v101, v97, s44
  v_perm_b32 v28, v101, v97, s45
  v_perm_b32 v25, v109, v105, s44
  v_perm_b32 v29, v109, v105, s45
  v_perm_b32 v26, v117, v113, s44
  v_perm_b32 v30, v117, v113, s45
  v_perm_b32 v27, v125, v121, s44
  v_perm_b32 v31, v125, v121, s45
  s_nop 1
  v_mfma_f32_16x16x32_bf16 a[8:11], v[24:27], v[44:47], a[8:11]
  v_mfma_f32_16x16x32_bf16 a[12:15], v[28:31], v[44:47], a[12:15]
  v_perm_b32 v16, v102, v98, s44
  v_perm_b32 v20, v102, v98, s45
  v_perm_b32 v17, v110, v106, s44
  v_perm_b32 v21, v110, v106, s45
  v_perm_b32 v18, v118, v114, s44
  v_perm_b32 v22, v118, v114, s45
  v_perm_b32 v19, v126, v122, s44
  v_perm_b32 v23, v126, v122, s45
  s_nop 1
  v_mfma_f32_16x16x32_bf16 a[16:19], v[16:19], v[44:47], a[16:19]
  v_mfma_f32_16x16x32_bf16 a[20:23], v[20:23], v[44:47], a[20:23]
  v_perm_b32 v24, v103, v99, s44
  v_perm_b32 v28, v103, v99, s45
  v_perm_b32 v25, v111, v107, s44
  v_perm_b32 v29, v111, v107, s45
  v_perm_b32 v26, v119, v115, s44
  v_perm_b32 v30, v119, v115, s45
  v_perm_b32 v27, v127, v123, s44
  v_perm_b32 v31, v127, v123, s45
  s_nop 1
  v_mfma_f32_16x16x32_bf16 a[24:27], v[24:27], v[44:47], a[24:27]
  v_mfma_f32_16x16x32_bf16 a[28:31], v[28:31], v[44:47], a[28:31]
  s_mov_b32 exec_lo, 0x00030003
  s_mov_b32 exec_hi, 0x00030003
  s_nop 5
  ds_write_b128 v12, a[0:3] offset:1024
  ds_write_b128 v12, a[4:7] offset:1088
  ds_write_b128 v12, a[8:11] offset:1152
  ds_write_b128 v12, a[12:15] offset:1216
  ds_write_b128 v12, a[16:19] offset:1280
  ds_write_b128 v12, a[20:23] offset:1344
  ds_write_b128 v12, a[24:27] offset:1408
  ds_write_b128 v12, a[28:31] offset:1472
  s_mov_b64 exec, -1
  s_waitcnt lgkmcnt(0)
  s_barrier
  s_cmp_lg_u32 s3, 0
  s_cbranch_scc1 L_done
L_tail:
  ds_read_b128 v[64:67], v3 offset:1024
  ds_read_b128 v[68:71], v3 offset:2048
  ds_read_b128 v[72:75], v3 offset:3072
  ds_read_b128 v[76:79], v3 offset:4096
  ds_read_b128 v[80:83], v3 offset:5120
  ds_read_b128 v[84:87], v3 offset:6144
  ds_read_b128 v[88:91], v3 offset:7168
  ds_read_b128 v[92:95], v3 offset:8192
  s_waitcnt lgkmcnt(7)
  s_waitcnt lgkmcnt(6)
  v_add_f32 v16, v64, v68
  v_add_f32 v17, v65, v69
  v_add_f32 v18, v66, v70
  v_add_f32 v19, v67, v71
  s_waitcnt lgkmcnt(5)
  v_add_f32 v16, v16, v72
  v_add_f32 v17, v17, v73
  v_add_f32 v18, v18, v74
  v_add_f32 v19, v19, v75
  s_waitcnt lgkmcnt(4)
  v_add_f32 v16, v16, v76
  v_add_f32 v17, v17, v77
  v_add_f32 v18, v18, v78
  v_add_f32 v19, v19, v79
  s_waitcnt lgkmcnt(3)
  v_add_f32 v16, v16, v80
  v_add_f32 v17, v17, v81
  v_add_f32 v18, v18, v82
  v_add_f32 v19, v19, v83
  s_waitcnt lgkmcnt(2)
  v_add_f32 v16, v16, v84
  v_add_f32 v17, v17, v85
  v_add_f32 v18, v18, v86
  v_add_f32 v19, v19, v87
  s_waitcnt lgkmcnt(1)
  v_add_f32 v16, v16, v88
  v_add_f32 v17, v17, v89
  v_add_f32 v18, v18, v90
  v_add_f32 v19, v19, v91
  s_waitcnt lgkmcnt(0)
  v_add_f32 v16, v16, v92
  v_add_f32 v17, v17, v93
  v_add_f32 v18, v18, v94
  v_add_f32 v19, v19, v95
  v_cvt_pk_bf16_f32 v20, v16, v17
  v_cvt_pk_bf16_f32 v21, v18, v19
  v_min_u32 v20, -2, v20
  v_min_u32 v21, -2, v21
  buffer_store_dwordx2 v[20:21], v6, s[32:35], s60 offen sc1
  s_cmp_eq_u32 s59, 0
  s_cbranch_scc1 L_t3
  ds_read_b64_tr_b16 a[0:1], v15 offset:9312
  ds_read_b64_tr_b16 a[2:3], v15 offset:13408
  ds_read_b64_tr_b16 a[4:5], v15 offset:9568
  ds_read_b64_tr_b16 a[6:7], v15 offset:13664
  ds_read_b64_tr_b16 a[8:9], v15 offset:9824
  ds_read_b64_tr_b16 a[10:11], v15 offset:13920
  ds_read_b64_tr_b16 a[12:13], v15 offset:10080
  ds_read_b64_tr_b16 a[14:15], v15 offset:14176
  s_waitcnt lgkmcnt(0)
  ds_read_b64_tr_b16 a[16:17], v15 offset:25696
  ds_read_b64_tr_b16 a[18:19], v15 offset:29792
  ds_read_b64_tr_b16 a[20:21], v15 offset:25952
  ds_read_b64_tr_b16 a[22:23], v15 offset:30048
  ds_read_b64_tr_b16 a[24:25], v15 offset:26208
  ds_read_b64_tr_b16 a[26:27], v15 offset:30304
  ds_read_b64_tr_b16 a[28:29], v15 offset:26464
  ds_read_b64_tr_b16 a[30:31], v15 offset:30560
  s_waitcnt lgkmcnt(0)
L_t3:
  s_mov_b32 s46, 262144
L_pollo:
  buffer_load_dwordx4 v[96:99], v7, s[32:35], s41 offen offset:0 sc1
  buffer_load_dwordx4 v[100:103], v7, s[32:35], s41 offen offset:64 sc1
  buffer_load_dwordx4 v[104:107], v7, s[32:35], s41 offen offset:128 sc1
  buffer_load_dwordx4 v[108:111], v7, s[32:35], s41 offen offset:192 sc1
  buffer_load_dwordx4 v[112:115], v7, s[32:35], s41 offen offset:256 sc1
  buffer_load_dwordx4 v[116:119], v7, s[32:35], s41 offen offset:320 sc1
  buffer_load_dwordx4 v[120:123], v7, s[32:35], s41 offen offset:384 sc1
  buffer_load_dwordx4 v[124:127], v7, s[32:35], s41 offen offset:448 sc1
  s_waitcnt vmcnt(0)
  v_max3_u32 v10, v96, v97, v98
  v_max3_u32 v10, v10, v99, v100
  v_max3_u32 v10, v10, v101, v102
  v_max3_u32 v10, v10, v103, v104
  v_max3_u32 v10, v10, v105, v106
  v_max3_u32 v10, v10, v107, v108
  v_max3_u32 v10, v10, v109, v110
  v_max3_u32 v10, v10, v111, v112
  v_max3_u32 v10, v10, v113, v114
  v_max3_u32 v10, v10, v115, v116
  v_max3_u32 v10, v10, v117, v118
  v_max3_u32 v10, v10, v119, v120
  v_max3_u32 v10, v10, v121, v122
  v_max3_u32 v10, v10, v123, v124
  v_max3_u32 v10, v10, v125, v126
  v_max_u32 v10, v10, v127
  v_cmp_eq_u32 vcc, -1, v10
  s_cbranch_vccz L_mo_ok0
  s_mov_b64 exec, vcc
  s_sub_u32 s46, s46, 1
  s_cmp_lg_u32 s46, 0
  s_cbranch_scc1 L_pollo
L_mo_ok0:
  s_mov_b64 exec, -1
  v_mfma_f32_16x16x32_bf16 v[32:35], a[32:35], v[96:99], 0
  v_mfma_f32_16x16x32_bf16 v[36:39], a[64:67], v[96:99], 0
  v_mfma_f32_16x16x32_bf16 v[32:35], a[36:39], v[100:103], v[32:35]
  v_mfma_f32_16x16x32_bf16 v[36:39], a[68:71], v[100:103], v[36:39]
  v_mfma_f32_16x16x32_bf16 v[32:35], a[40:43], v[104:107], v[32:35]
  v_mfma_f32_16x16x32_bf16 v[36:39], a[72:75], v[104:107], v[36:39]
  v_mfma_f32_16x16x32_bf16 v[32:35], a[44:47], v[108:111], v[32:35]
  v_mfma_f32_16x16x32_bf16 v[36:39], a[76:79], v[108:111], v[36:39]
  v_mfma_f32_16x16x32_bf16 v[32:35], a[48:51], v[112:115], v[32:35]
  v_mfma_f32_16x16x32_bf16 v[36:39], a[80:83], v[112:115], v[36:39]
  v_mfma_f32_16x16x32_bf16 v[32:35], a[52:55], v[116:119], v[32:35]
  v_mfma_f32_16x16x32_bf16 v[36:39], a[84:87], v[116:119], v[36:39]
  v_mfma_f32_16x16x32_bf16 v[32:35], a[56:59], v[120:123], v[32:35]
  v_mfma_f32_16x16x32_bf16 v[36:39], a[88:91], v[120:123], v[36:39]
  v_mfma_f32_16x16x32_bf16 v[32:35], a[60:63], v[124:127], v[32:35]
  v_mfma_f32_16x16x32_bf16 v[36:39], a[92:95], v[124:127], v[36:39]
  s_cmp_eq_u32 s59, 0
  s_cbranch_scc1 L_small
  v_mfma_f32_16x16x32_bf16 v[40:43], a[96:99], v[96:99], 0
  v_mfma_f32_16x16x32_bf16 v[44:47], a[0:3], v[96:99], 0
  v_mfma_f32_16x16x32_bf16 v[40:43], a[100:103], v[100:103], v[40:43]
  v_mfma_f32_16x16x32_bf16 v[44:47], a[4:7], v[100:103], v[44:47]
  v_mfma_f32_16x16x32_bf16 v[40:43], a[104:107], v[104:107], v[40:43]
  v_mfma_f32_16x16x32_bf16 v[44:47], a[8:11], v[104:107], v[44:47]
  v_mfma_f32_16x16x32_bf16 v[40:43], a[108:111], v[108:111], v[40:43]
  v_mfma_f32_16x16x32_bf16 v[44:47], a[12:15], v[108:111], v[44:47]
  v_mfma_f32_16x16x32_bf16 v[40:43], a[112:115], v[112:115], v[40:43]
  v_mfma_f32_16x16x32_bf16 v[44:47], a[16:19], v[112:115], v[44:47]
  v_mfma_f32_16x16x32_bf16 v[40:43], a[116:119], v[116:119], v[40:43]
  v_mfma_f32_16x16x32_bf16 v[44:47], a[20:23], v[116:119], v[44:47]
  v_mfma_f32_16x16x32_bf16 v[40:43], a[120:123], v[120:123], v[40:43]
  v_mfma_f32_16x16x32_bf16 v[44:47], a[24:27], v[120:123], v[44:47]
  v_mfma_f32_16x16x32_bf16 v[40:43], a[124:127], v[124:127], v[40:43]
  v_mfma_f32_16x16x32_bf16 v[44:47], a[28:31], v[124:127], v[44:47]
  s_nop 7
  v_min_u32 v40, -2, v40
  v_min_u32 v41, -2, v41
  v_min_u32 v42, -2, v42
  v_min_u32 v43, -2, v43
  v_min_u32 v44, -2, v44
  v_min_u32 v45, -2, v45
  v_min_u32 v46, -2, v46
  v_min_u32 v47, -2, v47
  buffer_store_dwordx4 v[40:43], v8, s[32:35], s43 offen offset:128 sc1
  buffer_store_dwordx4 v[44:47], v8, s[32:35], s43 offen offset:192 sc1
L_small:
  s_nop 5
  v_min_u32 v32, -2, v32
  v_min_u32 v33, -2, v33
  v_min_u32 v34, -2, v34
  v_min_u32 v35, -2, v35
  v_min_u32 v36, -2, v36
  v_min_u32 v37, -2, v37
  v_min_u32 v38, -2, v38
  v_min_u32 v39, -2, v39
  buffer_store_dwordx4 v[32:35], v8, s[32:35], s43 offen sc1
  buffer_store_dwordx4 v[36:39], v8, s[32:35], s43 offen offset:64 sc1
  s_mov_b32 exec_lo, -1
  s_mov_b32 exec_hi, s47
  s_mov_b32 s46, 262144
L_pollm:
  buffer_load_dword v16, v9, s[32:35], s40 offen offset:0 sc1
  buffer_load_dword v17, v9, s[32:35], s40 offen offset:256 sc1
  buffer_load_dword v18, v9, s[32:35], s40 offen offset:512 sc1
  buffer_load_dword v19, v9, s[32:35], s40 offen offset:768 sc1
  buffer_load_dword v20, v9, s[32:35], s40 offen offset:1024 sc1
  buffer_load_dword v21, v9, s[32:35], s40 offen offset:1280 sc1
  buffer_load_dword v22, v9, s[32:35], s40 offen offset:1536 sc1
  buffer_load_dword v23, v9, s[32:35], s40 offen offset:1792 sc1
  buffer_load_dword v24, v9, s[32:35], s40 offen offset:2048 sc1
  buffer_load_dword v25, v9, s[32:35], s40 offen offset:2304 sc1
  buffer_load_dword v26, v9, s[32:35], s40 offen offset:2560 sc1
  buffer_load_dword v27, v9, s[32:35], s40 offen offset:2816 sc1
  buffer_load_dword v28, v9, s[32:35], s40 offen offset:3072 sc1
  buffer_load_dword v29, v9, s[32:35], s40 offen offset:3328 sc1
  buffer_load_dword v30, v9, s[32:35], s40 offen offset:3584 sc1
  buffer_load_dword v31, v9, s[32:35], s40 offen offset:3840 sc1
  s_waitcnt vmcnt(0)
  v_max3_u32 v10, v16, v17, v18
  v_max3_u32 v10, v10, v19, v20
  v_max3_u32 v10, v10, v21, v22
  v_max3_u32 v10, v10, v23, v24
  v_max3_u32 v10, v10, v25, v26
  v_max3_u32 v10, v10, v27, v28
  v_max3_u32 v10, v10, v29, v30
  v_max_u32 v10, v10, v31
  v_cmp_eq_u32 vcc, -1, v10
  s_cbranch_vccz L_mr_ok0
  s_sub_u32 s46, s46, 1
  s_cmp_lg_u32 s46, 0
  s_cbranch_scc1 L_pollm
L_mr_ok0:
  v_add_f32 v16, v16, v17
  v_add_f32 v18, v18, v19
  v_add_f32 v20, v20, v21
  v_add_f32 v22, v22, v23
  v_add_f32 v24, v24, v25
  v_add_f32 v26, v26, v27
  v_add_f32 v28, v28, v29
  v_add_f32 v30, v30, v31
  v_add_f32 v16, v16, v18
  v_add_f32 v20, v20, v22
  v_add_f32 v24, v24, v26
  v_add_f32 v28, v28, v30
  v_add_f32 v16, v16, v20
  v_add_f32 v24, v24, v28
  v_add_f32 v10, v16, v24
  v_cvt_pk_bf16_f32 v10, v10, v10
  buffer_store_short v10, v11, s[28:31], s63 offen
  s_endpgm
L_w1:
  buffer_load_dwordx4 a[12:15], v2, s[8:11], s48 offen offset:2176 nt
  s_waitcnt vmcnt(3)
  buffer_load_dwordx4 a[16:19], v2, s[8:11], s49 offen offset:0 nt
  s_waitcnt vmcnt(3)
  buffer_load_dwordx4 a[20:23], v2, s[8:11], s49 offen offset:128 nt
  s_waitcnt vmcnt(3)
  buffer_load_dwordx4 a[24:27], v2, s[8:11], s49 offen offset:2048 nt
  s_waitcnt vmcnt(3)
  buffer_load_dwordx4 a[28:31], v2, s[8:11], s49 offen offset:2176 nt
  s_waitcnt vmcnt(3)
  buffer_load_dwordx4 a[32:35], v2, s[8:11], s50 offen offset:0 nt
  s_mov_b32 m0, s7
  s_nop 0
  buffer_load_dwordx4 v10, s[24:27], s47 offen nt lds
  s_add_u32 s47, s47, 9216
  s_add_u32 s7, s7, 1024
  s_waitcnt vmcnt(4)
  buffer_load_dwordx4 a[36:39], v2, s[8:11], s50 offen offset:128 nt
  s_waitcnt vmcnt(4)
  buffer_load_dwordx4 a[40:43], v2, s[8:11], s50 offen offset:2048 nt
  s_waitcnt vmcnt(4)
  buffer_load_dwordx4 a[44:47], v2, s[8:11], s50 offen offset:2176 nt
  s_mov_b32 m0, s7
  s_nop 0
  buffer_load_dwordx4 v10, s[24:27], s47 offen nt lds
  s_add_u32 s47, s47, 9216
  s_add_u32 s7, s7, 1024
  s_waitcnt vmcnt(5)
  buffer_load_dwordx4 a[48:51], v2, s[8:11], s51 offen offset:0 nt
  s_waitcnt vmcnt(4)
  buffer_load_dwordx4 a[52:55], v2, s[8:11], s51 offen offset:128 nt
  s_waitcnt vmcnt(4)
  buffer_load_dwordx4 a[56:59], v2, s[8:11], s51 offen offset:2048 nt
  s_mov_b32 m0, s7
  s_nop 0
  buffer_load_dwordx4 v10, s[24:27], s47 offen nt lds
  s_add_u32 s47, s47, 9216
  s_add_u32 s7, s7, 1024
  s_waitcnt vmcnt(5)
  buffer_load_dwordx4 a[60:63], v2, s[8:11], s51 offen offset:2176 nt
  s_waitcnt vmcnt(4)
  buffer_load_dwordx4 a[64:67], v2, s[8:11], s52 offen offset:0 nt
  s_waitcnt vmcnt(4)
  buffer_load_dwordx4 a[68:71], v2, s[8:11], s52 offen offset:128 nt
  s_mov_b32 m0, s7
  s_nop 0
  buffer_load_dwordx4 v10, s[24:27], s47 offen nt lds
  s_waitcnt vmcnt(5)
  buffer_load_dwordx4 a[72:75], v2, s[8:11], s52 offen offset:2048 nt
  s_waitcnt vmcnt(4)
  buffer_load_dwordx4 a[76:79], v2, s[8:11], s52 offen offset:2176 nt
  s_mov_b32 s46, 262144
L_pollq:
  buffer_load_dwordx4 v[32:35], v3, s[32:35], s63 offen sc1
  buffer_load_dwordx4 v[36:39], v3, s[32:35], s63 offen offset:1024 sc1
  s_waitcnt vmcnt(0)
  v_max3_u32 v13, v32, v33, v34
  v_max3_u32 v13, v13, v35, v36
  v_max3_u32 v13, v13, v37, v38
  v_max_u32 v13, v13, v39
  v_cmp_eq_u32 vcc, -1, v13
  s_sub_u32 s46, s46, 1
  s_cmp_eq_u32 s46, 0
  s_cbranch_scc1 L_pollq_done
  s_cbranch_vccz L_pollq_done
  s_sleep 12
  s_branch L_pollq
L_pollq_done:
  v_add_f32 v32, v32, v36
  v_add_f32 v33, v33, v37
  v_add_f32 v34, v34, v38
  v_add_f32 v35, v35, v39
  v_cvt_pk_bf16_f32 v36, v32, v33
  v_cvt_pk_bf16_f32 v37, v34, v35
  v_lshlrev_b32 v12, 3, v1
  ds_write_b64 v12, v[36:37] offset:0
  s_waitcnt lgkmcnt(0)
  v_mov_b32 v12, 0
  v_mov_b32 v13, 256
  s_mov_b64 exec, 1
  ds_add_u32 v12, v13 offset:768
  s_mov_b64 exec, -1
  s_waitcnt lgkmcnt(0)
  v_mov_b32 v10, 0
  v_mov_b32 v11, 1
  s_mov_b64 exec, 1
  ds_add_u32 v10, v11 offset:768
  s_mov_b64 exec, -1
  buffer_load_dwordx4 a[80:83], v2, s[8:11], s53 offen offset:0 nt
  buffer_load_dwordx4 a[84:87], v2, s[8:11], s53 offen offset:128 nt
  buffer_load_dwordx4 a[88:91], v2, s[8:11], s53 offen offset:2048 nt
  buffer_load_dwordx4 a[92:95], v2, s[8:11], s53 offen offset:2176 nt
  s_waitcnt vmcnt(3)
  buffer_load_dwordx4 a[96:99], v2, s[8:11], s54 offen offset:0 nt
  s_waitcnt vmcnt(3)
  buffer_load_dwordx4 a[100:103], v2, s[8:11], s54 offen offset:128 nt
  s_waitcnt vmcnt(3)
  buffer_load_dwordx4 a[104:107], v2, s[8:11], s54 offen offset:2048 nt
  s_waitcnt vmcnt(3)
  buffer_load_dwordx4 a[108:111], v2, s[8:11], s54 offen offset:2176 nt
  s_waitcnt vmcnt(3)
  buffer_load_dwordx4 a[112:115], v2, s[8:11], s55 offen offset:0 nt
  s_waitcnt vmcnt(3)
  buffer_load_dwordx4 a[116:119], v2, s[8:11], s55 offen offset:128 nt
  s_waitcnt vmcnt(3)
  buffer_load_dwordx4 a[120:123], v2, s[8:11], s55 offen offset:2048 nt
  s_waitcnt vmcnt(3)
  buffer_load_dwordx4 a[124:127], v2, s[8:11], s55 offen offset:2176 nt
  s_branch L_vfirst
L_w0:
  v_lshlrev_b32 v14, 11, v5
  v_lshl_add_u32 v14, v4, 4, v14
  v_mov_b32 v124, -1
  v_mov_b32 v125, -1
  v_mov_b32 v126, -1
  v_mov_b32 v127, -1
  v_lshlrev_b32 v15, 12, v5
  v_lshl_add_u32 v15, v4, 4, v15
  s_lshl_b32 s41, s5, 16
  s_lshl_b32 s42, s4, 8
  s_add_u32 s41, s41, s42
  s_add_u32 s41, s41, 1179648
  buffer_store_dwordx4 v[124:127], v15, s[32:35], s41 offen sc1
  buffer_store_dwordx4 v[124:127], v15, s[32:35], s41 offen offset:64 sc1
  s_cmp_eq_u32 s59, 1
  s_cselect_b32 exec_lo, -1, 1
  s_cselect_b32 exec_hi, -1, 0
  buffer_store_dwordx4 v[124:127], v15, s[32:35], s41 offen offset:128 sc1
  buffer_store_dwordx4 v[124:127], v15, s[32:35], s41 offen offset:192 sc1
  s_mov_b64 exec, -1
  buffer_load_dwordx4 a[12:15], v2, s[8:11], s48 offen offset:2176 nt
  buffer_load_dwordx4 a[16:19], v2, s[8:11], s49 offen offset:0 nt
  buffer_load_dwordx4 a[20:23], v2, s[8:11], s49 offen offset:128 nt
  v_lshrrev_b32 v12, 2, v5
  v_lshl_add_u32 v12, v4, 3, v12
  v_lshlrev_b32 v12, 6, v12
  v_and_b32 v13, 3, v5
  v_lshl_add_u32 v12, v13, 3, v12
  s_lshl_b32 s60, s5, 4
  s_waitcnt vmcnt(28)
  ds_read_b64_tr_b16 v[68:69], v12 offset:41984
  ds_read_b64_tr_b16 v[70:71], v12 offset:42240
  ds_read_b64_tr_b16 v[72:73], v12 offset:42016
  ds_read_b64_tr_b16 v[74:75], v12 offset:42272
  ds_read_b64_tr_b16 v[76:77], v12 offset:44032
  ds_read_b64_tr_b16 v[78:79], v12 offset:44288
  ds_read_b64_tr_b16 v[80:81], v12 offset:44064
  ds_read_b64_tr_b16 v[82:83], v12 offset:44320
  ds_read_b64_tr_b16 v[84:85], v12 offset:46080
  ds_read_b64_tr_b16 v[86:87], v12 offset:46336
  ds_read_b64_tr_b16 v[88:89], v12 offset:46112
  ds_read_b64_tr_b16 v[90:91], v12 offset:46368
  s_waitcnt lgkmcnt(0)
  v_mfma_f32_16x16x32_bf16 v[116:119], v[68:71], v[32:35], 0
  v_mfma_f32_16x16x32_bf16 v[120:123], v[72:75], v[32:35], 0
  v_mfma_f32_16x16x32_bf16 v[116:119], v[76:79], v[36:39], v[116:119]
  v_mfma_f32_16x16x32_bf16 v[120:123], v[80:83], v[36:39], v[120:123]
  v_mfma_f32_16x16x32_bf16 v[116:119], v[84:87], v[40:43], v[116:119]
  v_mfma_f32_16x16x32_bf16 v[120:123], v[88:91], v[40:43], v[120:123]
  s_waitcnt vmcnt(19)
  ds_read_b64_tr_b16 v[92:93], v12 offset:48128
  ds_read_b64_tr_b16 v[94:95], v12 offset:48384
  ds_read_b64_tr_b16 v[96:97], v12 offset:48160
  ds_read_b64_tr_b16 v[98:99], v12 offset:48416
  ds_read_b64_tr_b16 v[100:101], v12 offset:50176
  ds_read_b64_tr_b16 v[102:103], v12 offset:50432
  ds_read_b64_tr_b16 v[104:105], v12 offset:50208
  ds_read_b64_tr_b16 v[106:107], v12 offset:50464
  ds_read_b64_tr_b16 v[108:109], v12 offset:52224
  ds_read_b64_tr_b16 v[110:111], v12 offset:52480
  ds_read_b64_tr_b16 v[112:113], v12 offset:52256
  ds_read_b64_tr_b16 v[114:115], v12 offset:52512
  s_waitcnt lgkmcnt(0)
  v_mfma_f32_16x16x32_bf16 v[116:119], v[92:95], v[44:47], v[116:119]
  v_mfma_f32_16x16x32_bf16 v[120:123], v[96:99], v[44:47], v[120:123]
  v_mfma_f32_16x16x32_bf16 v[116:119], v[100:103], v[48:51], v[116:119]
  v_mfma_f32_16x16x32_bf16 v[120:123], v[104:107], v[48:51], v[120:123]
  v_mfma_f32_16x16x32_bf16 v[116:119], v[108:111], v[52:55], v[116:119]
  v_mfma_f32_16x16x32_bf16 v[120:123], v[112:115], v[52:55], v[120:123]
  s_waitcnt vmcnt(10)
  ds_read_b64_tr_b16 v[68:69], v12 offset:54272
  ds_read_b64_tr_b16 v[70:71], v12 offset:54528
  ds_read_b64_tr_b16 v[72:73], v12 offset:54304
  ds_read_b64_tr_b16 v[74:75], v12 offset:54560
  ds_read_b64_tr_b16 v[76:77], v12 offset:56320
  ds_read_b64_tr_b16 v[78:79], v12 offset:56576
  ds_read_b64_tr_b16 v[80:81], v12 offset:56352
  ds_read_b64_tr_b16 v[82:83], v12 offset:56608
  ds_read_b64_tr_b16 v[84:85], v12 offset:58368
  ds_read_b64_tr_b16 v[86:87], v12 offset:58624
  ds_read_b64_tr_b16 v[88:89], v12 offset:58400
  ds_read_b64_tr_b16 v[90:91], v12 offset:58656
  s_waitcnt lgkmcnt(0)
  s_mov_b32 s61, 0
  s_atomic_add s61, s[76:77], s60 glc
  v_mfma_f32_16x16x32_bf16 v[116:119], v[68:71], v[56:59], v[116:119]
  v_mfma_f32_16x16x32_bf16 v[120:123], v[72:75], v[56:59], v[120:123]
  v_mfma_f32_16x16x32_bf16 v[116:119], v[76:79], v[60:63], v[116:119]
  v_mfma_f32_16x16x32_bf16 v[120:123], v[80:83], v[60:63], v[120:123]
  v_mfma_f32_16x16x32_bf16 v[116:119], v[84:87], v[64:67], v[116:119]
  v_mfma_f32_16x16x32_bf16 v[120:123], v[88:91], v[64:67], v[120:123]
  s_nop 7
  v_min_u32 v116, -2, v116
  v_min_u32 v117, -2, v117
  v_min_u32 v118, -2, v118
  v_min_u32 v119, -2, v119
  v_min_u32 v120, -2, v120
  v_min_u32 v121, -2, v121
  v_min_u32 v122, -2, v122
  v_min_u32 v123, -2, v123
  s_mov_b32 s46, 262144
L_sp3:
  s_waitcnt lgkmcnt(0)
  s_cmp_ge_u32 s61, 16
  s_cbranch_scc1 L_sp3_done
  s_sub_u32 s46, s46, 1
  s_cmp_eq_u32 s46, 0
  s_cbranch_scc1 L_sp3_done
  s_sleep 12
  s_mov_b32 s61, 0
  s_atomic_add s61, s[76:77], s60 glc
  s_branch L_sp3
L_sp3_done:
  s_waitcnt vmcnt(0)
  buffer_store_dwordx4 v[116:119], v14, s[32:35], s63 offen offset:0 sc1
  buffer_store_dwordx4 v[120:123], v14, s[32:35], s63 offen offset:64 sc1
  buffer_load_dwordx4 a[24:27], v2, s[8:11], s49 offen offset:2048 nt
  buffer_load_dwordx4 a[28:31], v2, s[8:11], s49 offen offset:2176 nt
  buffer_load_dwordx4 a[32:35], v2, s[8:11], s50 offen offset:0 nt
  s_mov_b32 m0, s7
  s_nop 0
  buffer_load_dwordx4 v10, s[24:27], s47 offen nt lds
  s_add_u32 s47, s47, 9216
  s_add_u32 s7, s7, 1024
  buffer_load_dwordx4 a[36:39], v2, s[8:11], s50 offen offset:128 nt
  s_waitcnt vmcnt(4)
  buffer_load_dwordx4 a[40:43], v2, s[8:11], s50 offen offset:2048 nt
  s_waitcnt vmcnt(4)
  buffer_load_dwordx4 a[44:47], v2, s[8:11], s50 offen offset:2176 nt
  s_mov_b32 m0, s7
  s_nop 0
  buffer_load_dwordx4 v10, s[24:27], s47 offen nt lds
  s_add_u32 s47, s47, 9216
  s_add_u32 s7, s7, 1024
  s_waitcnt vmcnt(5)
  buffer_load_dwordx4 a[48:51], v2, s[8:11], s51 offen offset:0 nt
  s_waitcnt vmcnt(4)
  buffer_load_dwordx4 a[52:55], v2, s[8:11], s51 offen offset:128 nt
  s_waitcnt vmcnt(4)
  buffer_load_dwordx4 a[56:59], v2, s[8:11], s51 offen offset:2048 nt
  s_mov_b32 m0, s7
  s_nop 0
  buffer_load_dwordx4 v10, s[24:27], s47 offen nt lds
  s_add_u32 s47, s47, 9216
  s_add_u32 s7, s7, 1024
  s_waitcnt vmcnt(5)
  buffer_load_dwordx4 a[60:63], v2, s[8:11], s51 offen offset:2176 nt
  s_waitcnt vmcnt(4)
  buffer_load_dwordx4 a[64:67], v2, s[8:11], s52 offen offset:0 nt
  s_waitcnt vmcnt(4)
  buffer_load_dwordx4 a[68:71], v2, s[8:11], s52 offen offset:128 nt
  s_mov_b32 m0, s7
  s_nop 0
  buffer_load_dwordx4 v10, s[24:27], s47 offen nt lds
  s_waitcnt vmcnt(5)
  buffer_load_dwordx4 a[72:75], v2, s[8:11], s52 offen offset:2048 nt
  s_waitcnt vmcnt(4)
  buffer_load_dwordx4 a[76:79], v2, s[8:11], s52 offen offset:2176 nt
  s_waitcnt vmcnt(4)
  buffer_load_dwordx4 a[80:83], v2, s[8:11], s53 offen offset:0 nt
  s_waitcnt vmcnt(4)
  buffer_load_dwordx4 a[84:87], v2, s[8:11], s53 offen offset:128 nt
  s_waitcnt vmcnt(3)
  s_waitcnt lgkmcnt(0)
  v_mov_b32 v10, 0
  v_mov_b32 v11, 1
  s_mov_b64 exec, 1
  ds_add_u32 v10, v11 offset:768
  s_mov_b64 exec, -1
  buffer_load_dwordx4 a[88:91], v2, s[8:11], s53 offen offset:2048 nt
  s_waitcnt vmcnt(3)
  buffer_load_dwordx4 a[92:95], v2, s[8:11], s53 offen offset:2176 nt
  s_waitcnt vmcnt(3)
  buffer_load_dwordx4 a[96:99], v2, s[8:11], s54 offen offset:0 nt
  s_waitcnt vmcnt(3)
  buffer_load_dwordx4 a[100:103], v2, s[8:11], s54 offen offset:128 nt
  s_waitcnt vmcnt(3)
  buffer_load_dwordx4 a[104:107], v2, s[8:11], s54 offen offset:2048 nt
  s_waitcnt vmcnt(3)
  buffer_load_dwordx4 a[108:111], v2, s[8:11], s54 offen offset:2176 nt
  s_waitcnt vmcnt(3)
  buffer_load_dwordx4 a[112:115], v2, s[8:11], s55 offen offset:0 nt
  s_waitcnt vmcnt(3)
  buffer_load_dwordx4 a[116:119], v2, s[8:11], s55 offen offset:128 nt
  s_waitcnt vmcnt(3)
  buffer_load_dwordx4 a[120:123], v2, s[8:11], s55 offen offset:2048 nt
  s_waitcnt vmcnt(3)
  buffer_load_dwordx4 a[124:127], v2, s[8:11], s55 offen offset:2176 nt
  s_branch L_vfirst
L_done:
  s_endpgm
.section .rodata,"a"
.p2align 6
.amdhsa_kernel standalone__sliding_block_cached__sampling_kernel
  .amdhsa_next_free_vgpr 256
  .amdhsa_next_free_sgpr 102
  .amdhsa_accum_offset 128
  .amdhsa_group_segment_fixed_size 0
  .amdhsa_kernarg_size 64
  .amdhsa_user_sgpr_count 2
  .amdhsa_user_sgpr_kernarg_segment_ptr 1
  .amdhsa_system_sgpr_workgroup_id_x 1
  .amdhsa_float_denorm_mode_32 3
.end_amdhsa_kernel
```
